```python
import torch

def _softmax(x, axis=-1):
    return torch.softmax(x, dim=axis)
def _gelu(x):
    return torch.nn.functional.gelu(x, approximate="tanh")
def _silu(x):
    return torch.nn.functional.silu(x)
def _sigmoid(x):
    return torch.sigmoid(x)
def _layernorm(x, axis=-1, eps=1e-5):
    m = x.mean(dim=axis, keepdim=True)
    v = x.var(dim=axis, keepdim=True, unbiased=False)
    return (x - m) / torch.sqrt(v + eps)
def _scatter_add(tgt, idx, src, axis=0):
    return tgt.clone().index_add_(axis, idx, src)
def _segment_sum(src, seg, n):
    out = torch.zeros((n,) + src.shape[1:], dtype=src.dtype)
    return out.index_add_(0, seg, src)
def _pad(x, pw):
    flat = tuple(v for pair in reversed(pw) for v in pair)
    return torch.nn.functional.pad(x, flat)

kernel_name = 'concat_heads__spectral_fnet__spectral_fnet__prompt'

def setup_inputs():

    _w = (lambda a: (lambda t: t.to(torch.bfloat16) if t.is_floating_point() else t)(torch.as_tensor(a)))
    def _A_setup():
        B, S, D = 1, 2048, 512
        ns = torch.arange(S)[:, None] * torch.arange(S)[None, :]
        nd = torch.arange(D)[:, None] * torch.arange(D)[None, :]
        Ws_re = torch.cos(-2.0 * torch.pi * ns / S).to(float)
        Ws_im = torch.sin(-2.0 * torch.pi * ns / S).to(float)
        Wd_re = torch.cos(-2.0 * torch.pi * nd / D).to(float)
        Wd_im = torch.sin(-2.0 * torch.pi * nd / D).to(float)
        return {
            "x": _w((lambda *s: torch.randn(*s, dtype=torch.bfloat16) * 0.05)(B, S, D)),
            "dft_seq_re": _w(Ws_re),
            "dft_seq_im": _w(Ws_im),
            "dft_hid_re": _w(Wd_re),
            "dft_hid_im": _w(Wd_im),
        }
    _A_in = _A_setup()

    def _B_setup():
        B, S, D = 1, 2048, 512
        ns = torch.arange(S)[:, None] * torch.arange(S)[None, :]
        nd = torch.arange(D)[:, None] * torch.arange(D)[None, :]
        Ws_re = torch.cos(-2.0 * torch.pi * ns / S).to(float)
        Ws_im = torch.sin(-2.0 * torch.pi * ns / S).to(float)
        Wd_re = torch.cos(-2.0 * torch.pi * nd / D).to(float)
        Wd_im = torch.sin(-2.0 * torch.pi * nd / D).to(float)
        return {
            "x": _w((lambda *s: torch.randn(*s, dtype=torch.bfloat16) * 0.05)(B, S, D)),
            "dft_seq_re": _w(Ws_re),
            "dft_seq_im": _w(Ws_im),
            "dft_hid_re": _w(Wd_re),
            "dft_hid_im": _w(Wd_im),
        }
    _B_in = _B_setup()

    return {
        "A_x": _A_in["x"],
        "A_dft_seq_re": _A_in["dft_seq_re"],
        "A_dft_seq_im": _A_in["dft_seq_im"],
        "A_dft_hid_re": _A_in["dft_hid_re"],
        "A_dft_hid_im": _A_in["dft_hid_im"],
        "B_x": _B_in["x"],
        "B_dft_seq_re": _B_in["dft_seq_re"],
        "B_dft_seq_im": _B_in["dft_seq_im"],
        "B_dft_hid_re": _B_in["dft_hid_re"],
        "B_dft_hid_im": _B_in["dft_hid_im"],
    }

def reference(A_x, A_dft_seq_re, A_dft_seq_im, A_dft_hid_re, A_dft_hid_im, B_x, B_dft_seq_re, B_dft_seq_im, B_dft_hid_re, B_dft_hid_im):
    def _A_ref(x, dft_seq_re, dft_seq_im, dft_hid_re, dft_hid_im):
        a = torch.einsum("bsd,ed->bse", x, dft_hid_re)
        b = torch.einsum("bsd,ed->bse", x, dft_hid_im)
        y = torch.einsum("ts,bse->bte", dft_seq_re, a) - torch.einsum("ts,bse->bte", dft_seq_im, b)
        return y

    def _B_ref(x, dft_seq_re, dft_seq_im, dft_hid_re, dft_hid_im):
        a = torch.einsum("bsd,ed->bse", x, dft_hid_re)
        b = torch.einsum("bsd,ed->bse", x, dft_hid_im)
        y = torch.einsum("ts,bse->bte", dft_seq_re, a) - torch.einsum("ts,bse->bte", dft_seq_im, b)
        return y

    a = _A_ref(A_x, A_dft_seq_re, A_dft_seq_im, A_dft_hid_re, A_dft_hid_im)
    b = _B_ref(B_x, B_dft_seq_re, B_dft_seq_im, B_dft_hid_re, B_dft_hid_im)
    return torch.concatenate([a, b], axis=-1)
```

```asm
; @launch grid=(272,1,1) block=(256,1,1) lds=49152
.amdgcn_target "amdgcn-amd-amdhsa--gfx950"
.text
.globl concat_heads__spectral_fnet__spectral_fnet__prompt_kernel
.p2align 8
.type concat_heads__spectral_fnet__spectral_fnet__prompt_kernel,@function
concat_heads__spectral_fnet__spectral_fnet__prompt_kernel:
  s_lshr_b32 s20, s2, 4
  s_lshl_b32 s20, s20, 3
  s_and_b32 s21, s2, 7
  s_add_u32 s20, s20, s21
  s_cmp_ge_u32 s20, 130
  s_cbranch_scc1 L_idle
  s_setprio 1
  s_load_dwordx2 s[4:5], s[0:1], 0
  s_load_dwordx2 s[6:7], s[0:1], 40
  s_load_dwordx4 s[64:67], s[0:1], 80
  s_load_dwordx2 s[68:69], s[0:1], 96
  v_lshrrev_b32 v1, 6, v0
  v_and_b32 v2, 63, v0
  s_bfe_u32 s22, s2, 0x10003
  v_readfirstlane_b32 s23, v1
  s_cmp_ge_u32 s20, 65
  s_cselect_b32 s24, 65, 0
  s_sub_u32 s25, s20, s24
  s_cmp_eq_u32 s25, 64
  s_cselect_b32 s27, 0xffffffc0, s25
  s_cselect_b32 s28, 0x3d000000, 0
  v_lshlrev_b32 v3, 4, v2
  s_lshl_b32 s29, s23, 9
  s_add_u32 s30, s29, s25
  s_lshl_b32 s30, s30, 10
  s_sub_u32 s31, s29, s27
  s_lshl_b32 s32, s23, 13
  s_cmp_lg_u32 s24, 0
  s_waitcnt lgkmcnt(0)
  s_cselect_b32 s4, s6, s4
  s_cselect_b32 s5, s7, s5
  s_mov_b32 s8, s4
  s_and_b32 s9, s5, 0xffff
  s_mov_b32 s10, 0x200000
  s_mov_b32 s11, 0x20000
  s_add_u32 m0, s32, 0
  s_add_u32 s33, s30, 0
  s_add_u32 s34, s31, 0
  buffer_load_dwordx4 v3, s[8:11], s33 offen lds
  s_and_b32 s34, s34, 2047
  s_add_u32 m0, s32, 1024
  s_lshl_b32 s34, s34, 10
  buffer_load_dwordx4 v3, s[8:11], s34 offen lds
  s_add_u32 m0, s32, 2048
  s_add_u32 s33, s30, 131072
  s_add_u32 s34, s31, 128
  buffer_load_dwordx4 v3, s[8:11], s33 offen lds
  s_and_b32 s34, s34, 2047
  s_add_u32 m0, s32, 3072
  s_lshl_b32 s34, s34, 10
  buffer_load_dwordx4 v3, s[8:11], s34 offen lds
  s_add_u32 m0, s32, 4096
  s_add_u32 s33, s30, 262144
  s_add_u32 s34, s31, 256
  buffer_load_dwordx4 v3, s[8:11], s33 offen lds
  s_and_b32 s34, s34, 2047
  s_add_u32 m0, s32, 5120
  s_lshl_b32 s34, s34, 10
  buffer_load_dwordx4 v3, s[8:11], s34 offen lds
  s_add_u32 m0, s32, 6144
  s_add_u32 s33, s30, 393216
  s_add_u32 s34, s31, 384
  buffer_load_dwordx4 v3, s[8:11], s33 offen lds
  s_and_b32 s34, s34, 2047
  s_add_u32 m0, s32, 7168
  s_lshl_b32 s34, s34, 10
  buffer_load_dwordx4 v3, s[8:11], s34 offen lds
  s_mov_b32 s12, s68
  s_and_b32 s13, s69, 0xffff
  s_mov_b32 s14, 0x240000
  s_mov_b32 s15, 0x20000
  s_mov_b32 s16, s66
  s_and_b32 s17, s67, 0xffff
  s_mov_b32 s18, 256
  s_mov_b32 s19, 0x20000
  s_and_b32 s45, s2, 7
  s_cmp_lg_u32 s24, 0
  s_cselect_b32 s46, 128, 0
  s_add_u32 s45, s45, s46
  s_mul_i32 s45, s45, 256
  s_add_u32 s45, s45, 0x210000
  v_and_b32 v4, 15, v2
  v_lshrrev_b32 v5, 4, v2
  s_lshl_b32 s35, s22, 4
  v_add_u32 v6, s35, v4
  v_cvt_f32_u32 v6, v6
  v_lshlrev_b32 v7, 2, v5
  v_cvt_f32_u32 v7, v7
  v_cvt_f32_u32 v38, v4
  v_mul_f32 v39, 0x3d000000, v6
  v_mul_f32 v6, 0x3b000000, v6
  v_mul_f32 v40, v7, v39
  v_mul_f32 v41, v7, v6
  v_mul_f32 v42, 0x3d800000, v38
  v_mul_f32 v43, v7, v42
  v_fma_f32 v44, v38, s28, v43
  v_fmamk_f32 v48, v39, 0x00000000, v40
  v_fmamk_f32 v49, v39, 0x3f800000, v40
  v_fmamk_f32 v50, v39, 0x40000000, v40
  v_fmamk_f32 v51, v39, 0x40400000, v40
  v_fmamk_f32 v52, v39, 0x41800000, v40
  v_fmamk_f32 v53, v39, 0x41880000, v40
  v_fmamk_f32 v54, v39, 0x41900000, v40
  v_fmamk_f32 v55, v39, 0x41980000, v40
  v_cos_f32 v56, v48
  v_sin_f32 v64, v48
  v_cos_f32 v57, v49
  v_sin_f32 v65, v49
  v_cos_f32 v58, v50
  v_sin_f32 v66, v50
  v_cos_f32 v59, v51
  v_sin_f32 v67, v51
  v_cos_f32 v60, v52
  v_sin_f32 v68, v52
  v_cos_f32 v61, v53
  v_sin_f32 v69, v53
  v_cos_f32 v62, v54
  v_sin_f32 v70, v54
  v_cos_f32 v63, v55
  v_sin_f32 v71, v55
  v_fmamk_f32 v72, v6, 0x00000000, v41
  v_fmamk_f32 v73, v6, 0x3f800000, v41
  v_fmamk_f32 v74, v6, 0x40000000, v41
  v_fmamk_f32 v75, v6, 0x40400000, v41
  v_cvt_pk_bf16_f32 v8, v56, v57
  v_cvt_pk_bf16_f32 v12, v64, v65
  v_cvt_pk_bf16_f32 v9, v58, v59
  v_cvt_pk_bf16_f32 v13, v66, v67
  v_cvt_pk_bf16_f32 v10, v60, v61
  v_cvt_pk_bf16_f32 v14, v68, v69
  v_cvt_pk_bf16_f32 v11, v62, v63
  v_cvt_pk_bf16_f32 v15, v70, v71
  v_cos_f32 v20, v72
  v_sin_f32 v24, v72
  v_cos_f32 v21, v73
  v_sin_f32 v25, v73
  v_cos_f32 v22, v74
  v_sin_f32 v26, v74
  v_cos_f32 v23, v75
  v_sin_f32 v27, v75
  v_xor_b32 v16, 0x80008000, v12
  v_xor_b32 v17, 0x80008000, v13
  v_xor_b32 v18, 0x80008000, v14
  v_xor_b32 v19, 0x80008000, v15
  v_fmamk_f32 v48, v42, 0x00000000, v43
  v_fmamk_f32 v52, v42, 0x00000000, v44
  v_fmamk_f32 v49, v42, 0x3f800000, v43
  v_fmamk_f32 v53, v42, 0x3f800000, v44
  v_fmamk_f32 v50, v42, 0x40000000, v43
  v_fmamk_f32 v54, v42, 0x40000000, v44
  v_fmamk_f32 v51, v42, 0x40400000, v43
  v_fmamk_f32 v55, v42, 0x40400000, v44
  v_cos_f32 v56, v48
  v_sin_f32 v60, v48
  v_cos_f32 v57, v49
  v_sin_f32 v61, v49
  v_cos_f32 v58, v50
  v_sin_f32 v62, v50
  v_cos_f32 v59, v51
  v_sin_f32 v63, v51
  v_add_f32 v64, 0x3e000000, v52
  v_add_f32 v68, 0xbe000000, v52
  v_add_f32 v65, 0x3e000000, v53
  v_add_f32 v69, 0xbe000000, v53
  v_add_f32 v66, 0x3e000000, v54
  v_add_f32 v70, 0xbe000000, v54
  v_add_f32 v67, 0x3e000000, v55
  v_add_f32 v71, 0xbe000000, v55
  v_cvt_pk_bf16_f32 v30, v56, v57
  v_cvt_pk_bf16_f32 v31, v58, v59
  v_cvt_pk_bf16_f32 v32, v60, v61
  v_cvt_pk_bf16_f32 v33, v62, v63
  v_cos_f32 v72, v64
  v_cos_f32 v76, v68
  v_cos_f32 v73, v65
  v_cos_f32 v77, v69
  v_cos_f32 v74, v66
  v_cos_f32 v78, v70
  v_cos_f32 v75, v67
  v_cos_f32 v79, v71
  v_xor_b32 v28, 0x80008000, v32
  v_xor_b32 v29, 0x80008000, v33
  v_cvt_pk_bf16_f32 v34, v72, v76
  v_cvt_pk_bf16_f32 v35, v73, v77
  v_cvt_pk_bf16_f32 v36, v74, v78
  v_cvt_pk_bf16_f32 v37, v75, v79
  v_lshlrev_b32 v38, 3, v2
  v_add_u32 v38, s32, v38
  v_bfe_u32 v40, v4, 1, 2
  v_xor_b32 v41, s23, v40
  v_xor_b32 v42, v5, v40
  v_lshlrev_b32 v43, 6, v4
  v_lshl_add_u32 v41, v41, 4, v43
  v_lshl_add_u32 v42, v42, 4, v43
  v_lshlrev_b32 v39, 12, v5
  v_add_u32 v39, v39, v41
  v_add_u32 v39, 0x8000, v39
  s_lshl_b32 s36, s23, 12
  s_add_u32 s36, s36, 0x8000
  v_add_u32 v6, s36, v42
  v_and_b32 v40, 1, v5
  v_lshrrev_b32 v41, 1, v5
  v_lshlrev_b32 v7, 10, v4
  v_lshl_add_u32 v7, v40, 6, v7
  v_lshl_add_u32 v7, v41, 4, v7
  s_lshl_b32 s37, s23, 8
  s_lshl_b32 s38, s22, 5
  s_add_u32 s37, s37, s38
  v_add_u32 v7, s37, v7
  s_lshl_b32 s39, s20, 14
  v_and_b32 v42, 7, v4
  v_lshrrev_b32 v43, 3, v4
  v_lshlrev_b32 v7, 10, v42
  v_lshl_add_u32 v7, v43, 6, v7
  v_lshl_add_u32 v7, v40, 5, v7
  v_lshl_add_u32 v7, v41, 4, v7
  s_lshl_b32 s37, s23, 7
  s_lshl_b32 s38, s22, 9
  s_add_u32 s37, s37, s38
  v_add_u32 v7, s37, v7
  s_add_u32 s40, s39, 8192
  s_waitcnt vmcnt(4)
  ds_read_b64_tr_b16 v[40:41], v38 offset:0
  ds_read_b64_tr_b16 v[42:43], v38 offset:512
  ds_read_b64_tr_b16 v[44:45], v38 offset:1024
  ds_read_b64_tr_b16 v[46:47], v38 offset:1536
  ds_read_b64_tr_b16 v[48:49], v38 offset:2048
  ds_read_b64_tr_b16 v[50:51], v38 offset:2560
  ds_read_b64_tr_b16 v[52:53], v38 offset:3072
  ds_read_b64_tr_b16 v[54:55], v38 offset:3584
  s_waitcnt vmcnt(0)
  ds_read_b64_tr_b16 v[56:57], v38 offset:4096
  ds_read_b64_tr_b16 v[58:59], v38 offset:4608
  ds_read_b64_tr_b16 v[60:61], v38 offset:5120
  ds_read_b64_tr_b16 v[62:63], v38 offset:5632
  ds_read_b64_tr_b16 v[64:65], v38 offset:6144
  ds_read_b64_tr_b16 v[66:67], v38 offset:6656
  ds_read_b64_tr_b16 v[68:69], v38 offset:7168
  ds_read_b64_tr_b16 v[70:71], v38 offset:7680
  s_waitcnt lgkmcnt(8)
  v_mfma_f32_16x16x32_bf16 v[72:75], v[40:43], v[8:11], 0
  v_mfma_f32_16x16x32_bf16 v[76:79], v[40:43], v[16:19], 0
  v_mfma_f32_16x16x32_bf16 v[72:75], v[44:47], v[12:15], v[72:75]
  v_mfma_f32_16x16x32_bf16 v[76:79], v[44:47], v[8:11], v[76:79]
  v_mfma_f32_16x16x32_bf16 v[80:83], v[48:51], v[8:11], 0
  v_mfma_f32_16x16x32_bf16 v[84:87], v[48:51], v[16:19], 0
  v_mfma_f32_16x16x32_bf16 v[80:83], v[52:55], v[12:15], v[80:83]
  v_mfma_f32_16x16x32_bf16 v[84:87], v[52:55], v[8:11], v[84:87]
  s_waitcnt lgkmcnt(0)
  v_mfma_f32_16x16x32_bf16 v[88:91], v[56:59], v[8:11], 0
  v_mfma_f32_16x16x32_bf16 v[92:95], v[56:59], v[16:19], 0
  v_mfma_f32_16x16x32_bf16 v[88:91], v[60:63], v[12:15], v[88:91]
  v_mfma_f32_16x16x32_bf16 v[92:95], v[60:63], v[8:11], v[92:95]
  v_mfma_f32_16x16x32_bf16 v[96:99], v[64:67], v[8:11], 0
  v_mfma_f32_16x16x32_bf16 v[100:103], v[64:67], v[16:19], 0
  v_mfma_f32_16x16x32_bf16 v[96:99], v[68:71], v[12:15], v[96:99]
  v_mfma_f32_16x16x32_bf16 v[100:103], v[68:71], v[8:11], v[100:103]
  v_mul_f32 v40, v72, v20
  v_mul_f32 v44, v76, v20
  v_mul_f32 v41, v73, v21
  v_mul_f32 v45, v77, v21
  v_mul_f32 v42, v74, v22
  v_mul_f32 v46, v78, v22
  v_mul_f32 v43, v75, v23
  v_mul_f32 v47, v79, v23
  v_fmac_f32 v40, v76, v24
  v_fma_f32 v44, -v72, v24, v44
  v_fmac_f32 v41, v77, v25
  v_fma_f32 v45, -v73, v25, v45
  v_fmac_f32 v42, v78, v26
  v_fma_f32 v46, -v74, v26, v46
  v_fmac_f32 v43, v79, v27
  v_fma_f32 v47, -v75, v27, v47
  v_cvt_pk_bf16_f32 v104, v40, v41
  v_cvt_pk_bf16_f32 v105, v42, v43
  v_cvt_pk_bf16_f32 v106, v44, v45
  v_cvt_pk_bf16_f32 v107, v46, v47
  v_mul_f32 v48, v80, v20
  v_mul_f32 v52, v84, v20
  v_mul_f32 v49, v81, v21
  v_mul_f32 v53, v85, v21
  v_mul_f32 v50, v82, v22
  v_mul_f32 v54, v86, v22
  v_mul_f32 v51, v83, v23
  v_mul_f32 v55, v87, v23
  v_fmac_f32 v48, v84, v24
  v_fma_f32 v52, -v80, v24, v52
  v_fmac_f32 v49, v85, v25
  v_fma_f32 v53, -v81, v25, v53
  v_fmac_f32 v50, v86, v26
  v_fma_f32 v54, -v82, v26, v54
  v_fmac_f32 v51, v87, v27
  v_fma_f32 v55, -v83, v27, v55
  v_cvt_pk_bf16_f32 v108, v48, v49
  v_cvt_pk_bf16_f32 v109, v50, v51
  v_cvt_pk_bf16_f32 v110, v52, v53
  v_cvt_pk_bf16_f32 v111, v54, v55
  v_mfma_f32_16x16x32_bf16 v[120:123], v[30:33], v[104:107], 0
  v_mfma_f32_16x16x32_bf16 v[124:127], v[28:31], v[104:107], 0
  v_mul_f32 v56, v88, v20
  v_mul_f32 v60, v92, v20
  v_mul_f32 v57, v89, v21
  v_mul_f32 v61, v93, v21
  v_mul_f32 v58, v90, v22
  v_mul_f32 v62, v94, v22
  v_mul_f32 v59, v91, v23
  v_mul_f32 v63, v95, v23
  v_fmac_f32 v56, v92, v24
  v_fma_f32 v60, -v88, v24, v60
  v_fmac_f32 v57, v93, v25
  v_fma_f32 v61, -v89, v25, v61
  v_fmac_f32 v58, v94, v26
  v_fma_f32 v62, -v90, v26, v62
  v_fmac_f32 v59, v95, v27
  v_fma_f32 v63, -v91, v27, v63
  v_cvt_pk_bf16_f32 v112, v56, v57
  v_cvt_pk_bf16_f32 v113, v58, v59
  v_cvt_pk_bf16_f32 v114, v60, v61
  v_cvt_pk_bf16_f32 v115, v62, v63
  v_mfma_f32_16x16x32_bf16 v[128:131], v[30:33], v[108:111], 0
  v_mfma_f32_16x16x32_bf16 v[132:135], v[28:31], v[108:111], 0
  v_mul_f32 v64, v96, v20
  v_mul_f32 v68, v100, v20
  v_mul_f32 v65, v97, v21
  v_mul_f32 v69, v101, v21
  v_mul_f32 v66, v98, v22
  v_mul_f32 v70, v102, v22
  v_mul_f32 v67, v99, v23
  v_mul_f32 v71, v103, v23
  v_fmac_f32 v64, v100, v24
  v_fma_f32 v68, -v96, v24, v68
  v_fmac_f32 v65, v101, v25
  v_fma_f32 v69, -v97, v25, v69
  v_fmac_f32 v66, v102, v26
  v_fma_f32 v70, -v98, v26, v70
  v_fmac_f32 v67, v103, v27
  v_fma_f32 v71, -v99, v27, v71
  v_cvt_pk_bf16_f32 v116, v64, v65
  v_cvt_pk_bf16_f32 v117, v66, v67
  v_cvt_pk_bf16_f32 v118, v68, v69
  v_cvt_pk_bf16_f32 v119, v70, v71
  v_mfma_f32_16x16x32_bf16 v[136:139], v[30:33], v[112:115], 0
  v_mfma_f32_16x16x32_bf16 v[140:143], v[28:31], v[112:115], 0
  v_cvt_pk_bf16_f32 v152, v120, v124
  v_cvt_pk_bf16_f32 v156, v121, v125
  v_cvt_pk_bf16_f32 v160, v122, v126
  v_cvt_pk_bf16_f32 v164, v123, v127
  v_mfma_f32_16x16x32_bf16 v[144:147], v[30:33], v[116:119], 0
  v_mfma_f32_16x16x32_bf16 v[148:151], v[28:31], v[116:119], 0
  v_cvt_pk_bf16_f32 v153, v128, v132
  v_cvt_pk_bf16_f32 v157, v129, v133
  v_cvt_pk_bf16_f32 v161, v130, v134
  v_cvt_pk_bf16_f32 v165, v131, v135
  s_nop 1
  v_cvt_pk_bf16_f32 v154, v136, v140
  v_cvt_pk_bf16_f32 v158, v137, v141
  v_cvt_pk_bf16_f32 v162, v138, v142
  v_cvt_pk_bf16_f32 v166, v139, v143
  s_nop 1
  v_cvt_pk_bf16_f32 v155, v144, v148
  v_cvt_pk_bf16_f32 v159, v145, v149
  v_cvt_pk_bf16_f32 v163, v146, v150
  v_cvt_pk_bf16_f32 v167, v147, v151
  ds_write_b128 v39, v[152:155] offset:0
  ds_write_b128 v39, v[156:159] offset:1024
  ds_write_b128 v39, v[160:163] offset:2048
  ds_write_b128 v39, v[164:167] offset:3072
  s_waitcnt lgkmcnt(0)
  s_barrier
  ds_read_b128 v[168:171], v6 offset:0
  ds_read_b128 v[172:175], v6 offset:1024
  ds_read_b128 v[176:179], v6 offset:2048
  ds_read_b128 v[180:183], v6 offset:3072
  s_cmp_lg_u32 s23, 0
  s_cbranch_scc1 L_noif
  v_mov_b32 v18, 0
  buffer_load_dword v19, v18, s[16:19], 0 offen sc1
L_noif:
  s_waitcnt lgkmcnt(3)
  v_mfma_f32_16x16x32_bf16 v[184:187], v[168:171], v[34:37], 0
  s_waitcnt lgkmcnt(2)
  v_mfma_f32_16x16x32_bf16 v[188:191], v[172:175], v[34:37], 0
  s_waitcnt lgkmcnt(1)
  v_mfma_f32_16x16x32_bf16 v[192:195], v[176:179], v[34:37], 0
  s_waitcnt lgkmcnt(0)
  v_mfma_f32_16x16x32_bf16 v[196:199], v[180:183], v[34:37], 0
  s_nop 4
  v_cvt_pk_bf16_f32 v200, v184, v185
  v_cvt_pk_bf16_f32 v201, v186, v187
  v_cvt_pk_bf16_f32 v202, v188, v189
  v_cvt_pk_bf16_f32 v203, v190, v191
  s_nop 1
  v_permlane16_swap_b32 v200, v202
  v_permlane16_swap_b32 v201, v203
  s_mov_b32 vcc_lo, 0x00ff00ff
  s_mov_b32 vcc_hi, 0x00ff00ff
  s_nop 1
  v_cvt_pk_bf16_f32 v204, v192, v193
  v_cvt_pk_bf16_f32 v205, v194, v195
  v_cvt_pk_bf16_f32 v206, v196, v197
  v_cvt_pk_bf16_f32 v207, v198, v199
  s_nop 1
  v_permlane16_swap_b32 v204, v206
  v_permlane16_swap_b32 v205, v207
  s_nop 1
  v_cndmask_b32_dpp v184, v204, v200, vcc row_ror:8 row_mask:0xf bank_mask:0xf
  v_cndmask_b32_dpp v185, v205, v201, vcc row_ror:8 row_mask:0xf bank_mask:0xf
  v_cndmask_b32_dpp v186, v206, v202, vcc row_ror:8 row_mask:0xf bank_mask:0xf
  v_cndmask_b32_dpp v187, v207, v203, vcc row_ror:8 row_mask:0xf bank_mask:0xf
  s_not_b64 vcc, vcc
  buffer_store_dwordx4 v[184:187], v7, s[12:15], s39 offen sc1
  v_cndmask_b32_dpp v188, v200, v204, vcc row_ror:8 row_mask:0xf bank_mask:0xf
  v_cndmask_b32_dpp v189, v201, v205, vcc row_ror:8 row_mask:0xf bank_mask:0xf
  v_cndmask_b32_dpp v190, v202, v206, vcc row_ror:8 row_mask:0xf bank_mask:0xf
  v_cndmask_b32_dpp v191, v203, v207, vcc row_ror:8 row_mask:0xf bank_mask:0xf
  buffer_store_dwordx4 v[188:191], v7, s[12:15], s40 offen sc1
  s_setprio 0
  s_cmp_ge_u32 s2, 256
  s_cbranch_scc1 L_drain
  s_and_b32 s20, s2, 7
  s_bfe_u32 s21, s2, 0x10007
  s_bfe_u32 s22, s2, 0x10006
  s_bfe_u32 s24, s2, 0x30003
  s_sub_u32 s25, 16, s20
  s_cmp_eq_u32 s20, 0
  s_cselect_b32 s25, 8, s25
  s_cmp_lg_u32 s22, 0
  s_cselect_b32 s25, s25, s20
  s_sub_u32 s26, 16, s25
  s_and_b32 s26, s26, 15
  s_sub_u32 s27, 7, s24
  s_mul_i32 s28, s21, 65
  s_lshl_b32 s29, s23, 4
  s_add_u32 s28, s28, s29
  s_lshl_b32 s28, s28, 14
  s_lshl_b32 s29, s25, 10
  s_lshl_b32 s30, s24, 6
  s_add_u32 s29, s29, s30
  s_add_u32 s29, s29, s28
  s_lshl_b32 s30, s26, 10
  s_add_u32 s30, s30, s28
  s_lshl_b32 s31, s27, 6
  s_add_u32 s31, s31, s30
  v_lshrrev_b32 v3, 3, v2
  v_and_b32 v1, 7, v2
  v_lshlrev_b32 v6, 1, v5
  v_xor_b32 v6, v1, v6
  v_lshlrev_b32 v0, 14, v3
  v_bfe_u32 v8, v2, 1, 1
  v_bfe_u32 v9, v2, 2, 1
  v_lshlrev_b32 v8, 9, v8
  v_lshl_add_u32 v8, v9, 5, v8
  v_and_b32 v9, 1, v2
  v_lshl_add_u32 v8, v9, 4, v8
  v_xor_b32 v9, 0x230, v8
  v_add_u32 v8, v0, v8
  v_add_u32 v9, v0, v9
  s_add_u32 s32, s27, 1
  s_and_b32 s32, s32, 7
  s_lshl_b32 s32, s32, 6
  s_add_u32 s30, s30, s32
  s_cmp_eq_u32 s23, 0
  s_cselect_b32 s32, 0x100000, 0
  v_mov_b32 v10, s32
  v_cmp_gt_u32 vcc, 8, v2
  s_lshl_b32 s33, s23, 11
  s_add_u32 s34, s29, 0x20000
  v_cndmask_b32 v10, 0, v10, vcc
  v_add_u32 v11, v9, v10
  v_add_u32 v12, v0, v10
  s_add_u32 s35, s31, 0x20000
  v_lshlrev_b32 v13, 7, v3
  v_lshl_add_u32 v13, v6, 4, v13
  v_add_u32 v13, s33, v13
  v_bfe_u32 v30, v2, 2, 2
  v_and_b32 v31, 3, v2
  v_lshl_add_u32 v32, v5, 2, v30
  v_bfe_u32 v33, v32, 1, 2
  v_lshlrev_b32 v32, 7, v32
  v_lshl_add_u32 v32, v31, 3, v32
  v_xor_b32 v26, 0, v33
  v_lshl_add_u32 v26, v26, 5, v32
  v_xor_b32 v27, 1, v33
  v_lshl_add_u32 v27, v27, 5, v32
  v_xor_b32 v28, 2, v33
  v_lshl_add_u32 v28, v28, 5, v32
  v_xor_b32 v29, 3, v33
  v_lshl_add_u32 v29, v29, 5, v32
  v_and_b32 v30, 7, v4
  v_lshlrev_b32 v14, 15, v30
  v_lshrrev_b32 v30, 3, v4
  v_lshl_add_u32 v14, v30, 6, v14
  v_and_b32 v30, 1, v5
  v_lshl_add_u32 v14, v30, 5, v14
  v_lshrrev_b32 v30, 1, v5
  v_lshl_add_u32 v14, v30, 4, v14
  s_lshl_b32 s37, s23, 9
  s_add_u32 s37, s37, s25
  s_lshl_b32 s38, s37, 11
  s_lshl_b32 s39, s21, 10
  s_add_u32 s38, s38, s39
  s_lshl_b32 s39, s24, 7
  s_add_u32 s38, s38, s39
  v_and_b32 v35, 15, v2
  v_cmp_gt_u32 vcc, 2, v35
  v_mov_b32 v15, 8
  s_lshl_b32 s46, s21, 7
  v_lshlrev_b32 v35, 2, v35
  v_addc_co_u32 v15, vcc, 0, v15, vcc
  v_add_u32 v35, s46, v35
  v_and_b32 v35, 7, v2
  v_cmp_eq_u32 vcc, s21, v35
  v_mov_b32 v15, 16
  v_and_b32 v35, 7, v2
  s_mul_i32 s46, s21, 32768
  v_cndmask_b32 v16, 0, 2, vcc
  s_and_b32 s47, s2, 15
  s_mul_i32 s47, s47, 2048
  s_add_u32 s46, s46, s47
  v_add_u32 v15, v15, v16
  s_add_u32 s46, s46, 0x210000
  v_mul_u32_u24 v35, 256, v35
  v_add_u32 v35, s46, v35
  v_lshlrev_b32 v30, 4, v4
  v_add_u32 v30, s37, v30
  v_cvt_f32_u32 v30, v30
  v_lshlrev_b32 v31, 2, v5
  v_cvt_f32_u32 v31, v31
  v_mul_f32 v30, 0x3a000000, v30
  v_add_f32 v32, 0x3e000000, v30
  s_cmp_lg_u32 s25, 0
  s_cselect_b32 s40, 1, 0
  v_add_u32 v33, s40, v4
  v_and_b32 v33, 1, v33
  v_lshlrev_b32 v33, 31, v33
  v_xor_b32 v33, 0xbf3504f3, v33
  v_mov_b32 v34, 0x3e000000
  v_cmp_eq_u32 s[42:43], 0, v5
  v_cos_f32 v172, v30
  v_sin_f32 v173, v30
  v_fma_f32 v180, v31, v30, -v34
  v_cos_f32 v176, v32
  v_sin_f32 v177, v32
  v_fma_f32 v181, v31, v32, -v34
  v_xor_b32 v174, 0x80000000, v173
  v_add_f32 v175, v172, v172
  v_xor_b32 v178, 0x80000000, v177
  v_add_f32 v179, v176, v176
  v_mov_b32 v182, v180
  v_mov_b32 v191, v181
  v_cos_f32 v183, v182
  v_sin_f32 v187, v182
  v_cos_f32 v192, v191
  v_sin_f32 v196, v191
  v_mul_f32 v184, v183, v172
  v_mul_f32 v188, v187, v172
  v_mul_f32 v193, v192, v176
  v_mul_f32 v197, v196, v176
  v_fmac_f32 v184, v187, v174
  v_fmac_f32 v188, v183, v173
  v_fmac_f32 v193, v196, v178
  v_fmac_f32 v197, v192, v177
  v_fma_f32 v185, v175, v184, -v183
  v_fma_f32 v189, v175, v188, -v187
  v_fma_f32 v194, v179, v193, -v192
  v_fma_f32 v198, v179, v197, -v196
  v_fma_f32 v186, v175, v185, -v184
  v_fma_f32 v190, v175, v189, -v188
  v_fma_f32 v195, v179, v194, -v193
  v_fma_f32 v199, v179, v198, -v197
  v_cvt_pk_bf16_f32 v36, v183, v184
  v_cvt_pk_bf16_f32 v37, v185, v186
  v_cndmask_b32 v187, v187, v33, s[42:43]
  v_cvt_pk_bf16_f32 v45, -v189, -v190
  v_cvt_pk_bf16_f32 v52, v192, v193
  v_cvt_pk_bf16_f32 v53, v194, v195
  v_cndmask_b32 v196, v196, v33, s[42:43]
  v_cvt_pk_bf16_f32 v61, -v198, -v199
  v_cvt_pk_bf16_f32 v44, -v187, -v188
  v_cvt_pk_bf16_f32 v60, -v196, -v197
  v_fmamk_f32 v182, v30, 0x41800000, v180
  v_fmamk_f32 v191, v32, 0x41800000, v181
  v_cos_f32 v183, v182
  v_sin_f32 v187, v182
  v_cos_f32 v192, v191
  v_sin_f32 v196, v191
  v_mul_f32 v184, v183, v172
  v_mul_f32 v188, v187, v172
  v_mul_f32 v193, v192, v176
  v_mul_f32 v197, v196, v176
  v_fmac_f32 v184, v187, v174
  v_fmac_f32 v188, v183, v173
  v_fmac_f32 v193, v196, v178
  v_fmac_f32 v197, v192, v177
  v_fma_f32 v185, v175, v184, -v183
  v_fma_f32 v189, v175, v188, -v187
  v_fma_f32 v194, v179, v193, -v192
  v_fma_f32 v198, v179, v197, -v196
  v_fma_f32 v186, v175, v185, -v184
  v_fma_f32 v190, v175, v189, -v188
  v_fma_f32 v195, v179, v194, -v193
  v_fma_f32 v199, v179, v198, -v197
  v_cvt_pk_bf16_f32 v38, v183, v184
  v_cvt_pk_bf16_f32 v39, v185, v186
  v_cvt_pk_bf16_f32 v47, -v189, -v190
  v_cvt_pk_bf16_f32 v54, v192, v193
  v_cvt_pk_bf16_f32 v55, v194, v195
  v_cvt_pk_bf16_f32 v63, -v198, -v199
  v_cvt_pk_bf16_f32 v46, -v187, -v188
  v_cvt_pk_bf16_f32 v62, -v196, -v197
  v_fmamk_f32 v182, v30, 0x42000000, v180
  v_fmamk_f32 v191, v32, 0x42000000, v181
  v_cos_f32 v183, v182
  v_sin_f32 v187, v182
  v_cos_f32 v192, v191
  v_sin_f32 v196, v191
  v_mul_f32 v184, v183, v172
  v_mul_f32 v188, v187, v172
  v_mul_f32 v193, v192, v176
  v_mul_f32 v197, v196, v176
  v_fmac_f32 v184, v187, v174
  v_fmac_f32 v188, v183, v173
  v_fmac_f32 v193, v196, v178
  v_fmac_f32 v197, v192, v177
  v_fma_f32 v185, v175, v184, -v183
  v_fma_f32 v189, v175, v188, -v187
  v_fma_f32 v194, v179, v193, -v192
  v_fma_f32 v198, v179, v197, -v196
  v_fma_f32 v186, v175, v185, -v184
  v_fma_f32 v190, v175, v189, -v188
  v_fma_f32 v195, v179, v194, -v193
  v_fma_f32 v199, v179, v198, -v197
  v_cvt_pk_bf16_f32 v40, v183, v184
  v_cvt_pk_bf16_f32 v41, v185, v186
  v_cvt_pk_bf16_f32 v49, -v189, -v190
  v_cvt_pk_bf16_f32 v56, v192, v193
  v_cvt_pk_bf16_f32 v57, v194, v195
  v_cvt_pk_bf16_f32 v65, -v198, -v199
  v_cvt_pk_bf16_f32 v48, -v187, -v188
  v_cvt_pk_bf16_f32 v64, -v196, -v197
  v_fmamk_f32 v182, v30, 0x42400000, v180
  v_fmamk_f32 v191, v32, 0x42400000, v181
  v_cos_f32 v183, v182
  v_sin_f32 v187, v182
  v_cos_f32 v192, v191
  v_sin_f32 v196, v191
  v_mul_f32 v184, v183, v172
  v_mul_f32 v188, v187, v172
  v_mul_f32 v193, v192, v176
  v_mul_f32 v197, v196, v176
  v_fmac_f32 v184, v187, v174
  v_fmac_f32 v188, v183, v173
  v_fmac_f32 v193, v196, v178
  v_fmac_f32 v197, v192, v177
  v_fma_f32 v185, v175, v184, -v183
  v_fma_f32 v189, v175, v188, -v187
  v_fma_f32 v194, v179, v193, -v192
  v_fma_f32 v198, v179, v197, -v196
  v_fma_f32 v186, v175, v185, -v184
  v_fma_f32 v190, v175, v189, -v188
  v_fma_f32 v195, v179, v194, -v193
  v_fma_f32 v199, v179, v198, -v197
  v_cvt_pk_bf16_f32 v42, v183, v184
  v_cvt_pk_bf16_f32 v43, v185, v186
  v_cvt_pk_bf16_f32 v51, -v189, -v190
  v_cvt_pk_bf16_f32 v58, v192, v193
  v_cvt_pk_bf16_f32 v59, v194, v195
  v_cvt_pk_bf16_f32 v67, -v198, -v199
  v_cvt_pk_bf16_f32 v50, -v187, -v188
  v_cvt_pk_bf16_f32 v66, -v196, -v197
  s_mov_b32 s8, s64
  s_and_b32 s9, s65, 0xffff
  s_mov_b32 s10, 0x400000
  s_mov_b32 s11, 0x20000
L_drain:
  s_waitcnt vmcnt(0)
  s_barrier
  s_cmp_lg_u32 s23, 0
  s_cbranch_scc1 L_nosig
  s_mov_b32 s47, 0x40000
L_ipoll:
  v_cmp_eq_u32 vcc, 0, v19
  s_cbranch_vccz L_iok
  s_sub_u32 s47, s47, 1
  s_cbranch_scc1 L_iok
  v_mov_b32 v16, 0
  buffer_load_dword v19, v16, s[16:19], 0 offen sc1
  s_waitcnt vmcnt(0)
  s_branch L_ipoll
L_iok:
  s_mov_b64 exec, 65535
  s_nop 0
  v_mul_u32_u24 v16, 2048, v2
  v_mov_b32 v17, 1
  v_add_u32 v16, s45, v16
  buffer_atomic_add v17, v16, s[12:15], 0 offen
  s_mov_b64 exec, -1
L_nosig:
  s_cmp_ge_u32 s2, 256
  s_cbranch_scc1 L_done
  s_cmp_lg_u32 s23, 0
  s_cbranch_scc1 L_np0
  buffer_load_dword v20, v35, s[12:15], 0 offen sc1
L_np0:
  s_cmp_eq_u32 s23, 0
  s_cbranch_scc1 L_pollw
  s_branch L_ready
L_pollw:
  s_mov_b32 s47, 0x40000
L_poll:
  s_waitcnt vmcnt(0)
  v_cmp_ne_u32 vcc, v20, v15
  s_cbranch_vccz L_ready
  buffer_load_dword v20, v35, s[12:15], 0 offen sc1
  s_sub_u32 s47, s47, 1
  s_cbranch_scc0 L_poll
L_ready:
  s_barrier
  s_setprio 1
  s_add_u32 s36, s30, 0x20000
  buffer_load_dwordx4 v[16:19], v11, s[12:15], s31 offen sc1
  buffer_load_ushort v24, v12, s[12:15], s30 offen sc1
  buffer_load_dwordx4 v[20:23], v9, s[12:15], s35 offen sc1
  buffer_load_ushort v25, v0, s[12:15], s36 offen sc1
  buffer_load_dwordx4 v[68:71], v8, s[12:15], s29 offen sc1
  buffer_load_dwordx4 v[72:75], v8, s[12:15], s34 offen sc1
  s_mov_b32 s44, 0xffff
  v_cmp_eq_u32 s[48:49], 0, v1
  s_waitcnt vmcnt(4)
  v_mov_b32_dpp v180, v16 row_shr:1 row_mask:0xf bank_mask:0xf
  v_bfi_b32 v173, s44, v19, v18
  v_bfi_b32 v174, s44, v18, v17
  v_bfi_b32 v175, s44, v17, v16
  v_cndmask_b32 v180, v180, v24, s[48:49]
  v_bfi_b32 v172, s44, v180, v19
  ds_write_b128 v13, v[172:175] offset:8192
  s_waitcnt vmcnt(2)
  v_mov_b32_dpp v181, v20 row_shr:1 row_mask:0xf bank_mask:0xf
  v_bfi_b32 v177, s44, v23, v22
  v_bfi_b32 v178, s44, v22, v21
  v_bfi_b32 v179, s44, v21, v20
  v_cndmask_b32 v181, v181, v25, s[48:49]
  v_bfi_b32 v176, s44, v181, v23
  ds_write_b128 v13, v[176:179] offset:9216
  s_waitcnt vmcnt(1)
  ds_write_b128 v13, v[68:71]
  s_waitcnt vmcnt(0)
  ds_write_b128 v13, v[72:75] offset:1024
  s_waitcnt lgkmcnt(0)
  s_barrier
L_nob:
  ds_read_b64_tr_b16 v[68:69], v26 offset:0
  ds_read_b64_tr_b16 v[70:71], v26 offset:2048
  ds_read_b64_tr_b16 v[72:73], v27 offset:0
  ds_read_b64_tr_b16 v[74:75], v27 offset:2048
  ds_read_b64_tr_b16 v[76:77], v28 offset:0
  ds_read_b64_tr_b16 v[78:79], v28 offset:2048
  ds_read_b64_tr_b16 v[80:81], v29 offset:0
  ds_read_b64_tr_b16 v[82:83], v29 offset:2048
  ds_read_b64_tr_b16 v[84:85], v26 offset:4096
  ds_read_b64_tr_b16 v[86:87], v26 offset:6144
  ds_read_b64_tr_b16 v[88:89], v27 offset:4096
  ds_read_b64_tr_b16 v[90:91], v27 offset:6144
  ds_read_b64_tr_b16 v[92:93], v28 offset:4096
  ds_read_b64_tr_b16 v[94:95], v28 offset:6144
  s_waitcnt lgkmcnt(12)
  v_mfma_f32_16x16x32_bf16 v[132:135], v[68:71], v[36:39], 0
  v_mfma_f32_16x16x32_bf16 v[148:151], v[68:71], v[52:55], 0
  ds_read_b64_tr_b16 v[96:97], v29 offset:4096
  ds_read_b64_tr_b16 v[98:99], v29 offset:6144
  s_waitcnt lgkmcnt(12)
  v_mfma_f32_16x16x32_bf16 v[136:139], v[72:75], v[36:39], 0
  v_mfma_f32_16x16x32_bf16 v[152:155], v[72:75], v[52:55], 0
  ds_read_b64_tr_b16 v[100:101], v26 offset:8192
  ds_read_b64_tr_b16 v[102:103], v26 offset:10240
  s_waitcnt lgkmcnt(12)
  v_mfma_f32_16x16x32_bf16 v[140:143], v[76:79], v[36:39], 0
  v_mfma_f32_16x16x32_bf16 v[156:159], v[76:79], v[52:55], 0
  ds_read_b64_tr_b16 v[104:105], v27 offset:8192
  ds_read_b64_tr_b16 v[106:107], v27 offset:10240
  s_waitcnt lgkmcnt(12)
  v_mfma_f32_16x16x32_bf16 v[144:147], v[80:83], v[36:39], 0
  v_mfma_f32_16x16x32_bf16 v[160:163], v[80:83], v[52:55], 0
  ds_read_b64_tr_b16 v[108:109], v28 offset:8192
  ds_read_b64_tr_b16 v[110:111], v28 offset:10240
  s_waitcnt lgkmcnt(12)
  v_mfma_f32_16x16x32_bf16 v[132:135], v[84:87], v[40:43], v[132:135]
  v_mfma_f32_16x16x32_bf16 v[148:151], v[84:87], v[56:59], v[148:151]
  ds_read_b64_tr_b16 v[112:113], v29 offset:8192
  ds_read_b64_tr_b16 v[114:115], v29 offset:10240
  s_waitcnt lgkmcnt(12)
  v_mfma_f32_16x16x32_bf16 v[136:139], v[88:91], v[40:43], v[136:139]
  v_mfma_f32_16x16x32_bf16 v[152:155], v[88:91], v[56:59], v[152:155]
  ds_read_b64_tr_b16 v[116:117], v26 offset:12288
  ds_read_b64_tr_b16 v[118:119], v26 offset:14336
  s_waitcnt lgkmcnt(12)
  v_mfma_f32_16x16x32_bf16 v[140:143], v[92:95], v[40:43], v[140:143]
  v_mfma_f32_16x16x32_bf16 v[156:159], v[92:95], v[56:59], v[156:159]
  ds_read_b64_tr_b16 v[120:121], v27 offset:12288
  ds_read_b64_tr_b16 v[122:123], v27 offset:14336
  s_waitcnt lgkmcnt(12)
  v_mfma_f32_16x16x32_bf16 v[144:147], v[96:99], v[40:43], v[144:147]
  v_mfma_f32_16x16x32_bf16 v[160:163], v[96:99], v[56:59], v[160:163]
  ds_read_b64_tr_b16 v[124:125], v28 offset:12288
  ds_read_b64_tr_b16 v[126:127], v28 offset:14336
  s_waitcnt lgkmcnt(12)
  v_mfma_f32_16x16x32_bf16 v[132:135], v[100:103], v[44:47], v[132:135]
  v_mfma_f32_16x16x32_bf16 v[148:151], v[100:103], v[60:63], v[148:151]
  ds_read_b64_tr_b16 v[128:129], v29 offset:12288
  ds_read_b64_tr_b16 v[130:131], v29 offset:14336
  s_waitcnt lgkmcnt(12)
  v_mfma_f32_16x16x32_bf16 v[136:139], v[104:107], v[44:47], v[136:139]
  v_mfma_f32_16x16x32_bf16 v[152:155], v[104:107], v[60:63], v[152:155]
  s_waitcnt lgkmcnt(10)
  v_mfma_f32_16x16x32_bf16 v[140:143], v[108:111], v[44:47], v[140:143]
  v_mfma_f32_16x16x32_bf16 v[156:159], v[108:111], v[60:63], v[156:159]
  s_waitcnt lgkmcnt(8)
  v_mfma_f32_16x16x32_bf16 v[144:147], v[112:115], v[44:47], v[144:147]
  v_mfma_f32_16x16x32_bf16 v[160:163], v[112:115], v[60:63], v[160:163]
  s_waitcnt lgkmcnt(6)
  v_mfma_f32_16x16x32_bf16 v[132:135], v[116:119], v[48:51], v[132:135]
  v_mfma_f32_16x16x32_bf16 v[148:151], v[116:119], v[64:67], v[148:151]
  s_waitcnt lgkmcnt(4)
  v_mfma_f32_16x16x32_bf16 v[136:139], v[120:123], v[48:51], v[136:139]
  v_mfma_f32_16x16x32_bf16 v[152:155], v[120:123], v[64:67], v[152:155]
  s_waitcnt lgkmcnt(2)
  v_mfma_f32_16x16x32_bf16 v[140:143], v[124:127], v[48:51], v[140:143]
  v_mfma_f32_16x16x32_bf16 v[156:159], v[124:127], v[64:67], v[156:159]
  s_waitcnt lgkmcnt(0)
  v_mfma_f32_16x16x32_bf16 v[144:147], v[128:131], v[48:51], v[144:147]
  v_mfma_f32_16x16x32_bf16 v[160:163], v[128:131], v[64:67], v[160:163]
  s_nop 1
  v_cvt_pk_bf16_f32 v164, v132, v133
  v_cvt_pk_bf16_f32 v165, v134, v135
  v_cvt_pk_bf16_f32 v166, v136, v137
  v_cvt_pk_bf16_f32 v167, v138, v139
  s_nop 1
  v_permlane16_swap_b32 v164, v166
  v_permlane16_swap_b32 v165, v167
  s_mov_b32 vcc_lo, 0x00ff00ff
  s_mov_b32 vcc_hi, 0x00ff00ff
  v_cvt_pk_bf16_f32 v168, v140, v141
  v_cvt_pk_bf16_f32 v169, v142, v143
  v_cvt_pk_bf16_f32 v170, v144, v145
  v_cvt_pk_bf16_f32 v171, v146, v147
  s_nop 1
  v_permlane16_swap_b32 v168, v170
  v_permlane16_swap_b32 v169, v171
  s_add_u32 s41, s38, 0
  s_add_u32 s40, s38, 262144
  v_cndmask_b32_dpp v180, v168, v164, vcc row_ror:8 row_mask:0xf bank_mask:0xf
  v_cndmask_b32_dpp v181, v169, v165, vcc row_ror:8 row_mask:0xf bank_mask:0xf
  v_cndmask_b32_dpp v182, v170, v166, vcc row_ror:8 row_mask:0xf bank_mask:0xf
  v_cndmask_b32_dpp v183, v171, v167, vcc row_ror:8 row_mask:0xf bank_mask:0xf
  s_not_b64 vcc, vcc
  buffer_store_dwordx4 v[180:183], v14, s[8:11], s41 offen sc1
  v_cndmask_b32_dpp v184, v164, v168, vcc row_ror:8 row_mask:0xf bank_mask:0xf
  v_cndmask_b32_dpp v185, v165, v169, vcc row_ror:8 row_mask:0xf bank_mask:0xf
  v_cndmask_b32_dpp v186, v166, v170, vcc row_ror:8 row_mask:0xf bank_mask:0xf
  v_cndmask_b32_dpp v187, v167, v171, vcc row_ror:8 row_mask:0xf bank_mask:0xf
  buffer_store_dwordx4 v[184:187], v14, s[8:11], s40 offen sc1
  v_cvt_pk_bf16_f32 v172, v148, v149
  v_cvt_pk_bf16_f32 v173, v150, v151
  v_cvt_pk_bf16_f32 v174, v152, v153
  v_cvt_pk_bf16_f32 v175, v154, v155
  s_nop 1
  v_permlane16_swap_b32 v172, v174
  v_permlane16_swap_b32 v173, v175
  s_mov_b32 vcc_lo, 0x00ff00ff
  s_mov_b32 vcc_hi, 0x00ff00ff
  v_cvt_pk_bf16_f32 v176, v156, v157
  v_cvt_pk_bf16_f32 v177, v158, v159
  v_cvt_pk_bf16_f32 v178, v160, v161
  v_cvt_pk_bf16_f32 v179, v162, v163
  s_nop 1
  v_permlane16_swap_b32 v176, v178
  v_permlane16_swap_b32 v177, v179
  s_add_u32 s41, s38, 524288
  s_add_u32 s40, s38, 786432
  v_cndmask_b32_dpp v188, v176, v172, vcc row_ror:8 row_mask:0xf bank_mask:0xf
  v_cndmask_b32_dpp v189, v177, v173, vcc row_ror:8 row_mask:0xf bank_mask:0xf
  v_cndmask_b32_dpp v190, v178, v174, vcc row_ror:8 row_mask:0xf bank_mask:0xf
  v_cndmask_b32_dpp v191, v179, v175, vcc row_ror:8 row_mask:0xf bank_mask:0xf
  s_not_b64 vcc, vcc
  buffer_store_dwordx4 v[188:191], v14, s[8:11], s41 offen sc1
  v_cndmask_b32_dpp v192, v172, v176, vcc row_ror:8 row_mask:0xf bank_mask:0xf
  v_cndmask_b32_dpp v193, v173, v177, vcc row_ror:8 row_mask:0xf bank_mask:0xf
  v_cndmask_b32_dpp v194, v174, v178, vcc row_ror:8 row_mask:0xf bank_mask:0xf
  v_cndmask_b32_dpp v195, v175, v179, vcc row_ror:8 row_mask:0xf bank_mask:0xf
  buffer_store_dwordx4 v[192:195], v14, s[8:11], s40 offen sc1
L_done:
  s_endpgm
L_idle:
  s_cmp_lg_u32 s2, 258
  s_cbranch_scc1 L_end
  s_nop 0
  s_load_dwordx4 s[64:67], s[0:1], 88
  v_cmp_gt_u32 vcc, 64, v0
  s_and_b64 exec, exec, vcc
  s_cbranch_execz L_end
  v_mul_u32_u24 v1, 256, v0
  v_mov_b32 v2, 0
  v_add_u32 v1, 0x210000, v1
  s_waitcnt lgkmcnt(0)
  s_mov_b32 s12, s66
  s_and_b32 s13, s67, 0xffff
  s_mov_b32 s14, 0x240000
  s_mov_b32 s15, 0x20000
  s_mov_b32 s16, s64
  s_and_b32 s17, s65, 0xffff
  s_mov_b32 s18, 256
  s_mov_b32 s19, 0x20000
  s_mov_b32 s20, 16384
  buffer_store_dword v2, v1, s[12:15], s20 offen sc1
  s_mov_b32 s20, 32768
  buffer_store_dword v2, v1, s[12:15], s20 offen sc1
  s_mov_b32 s20, 49152
  buffer_store_dword v2, v1, s[12:15], s20 offen sc1
  buffer_store_dword v2, v1, s[12:15], 0 offen sc1
  v_mov_b32 v3, 1
  s_mov_b64 exec, 1
  s_waitcnt vmcnt(0)
  buffer_store_dword v3, v2, s[16:19], 0 offen sc1
L_end:
  s_endpgm
.section .rodata,"a"
.p2align 6
.amdhsa_kernel concat_heads__spectral_fnet__spectral_fnet__prompt_kernel
  .amdhsa_next_free_vgpr 216
  .amdhsa_next_free_sgpr 96
  .amdhsa_accum_offset 216
  .amdhsa_group_segment_fixed_size 0
  .amdhsa_kernarg_size 104
  .amdhsa_user_sgpr_count 2
  .amdhsa_user_sgpr_kernarg_segment_ptr 1
  .amdhsa_system_sgpr_workgroup_id_x 1
.end_amdhsa_kernel
```
